```python
import torch

def _softmax(x, axis=-1):
    return torch.softmax(x, dim=axis)
def _gelu(x):
    return torch.nn.functional.gelu(x, approximate="tanh")
def _silu(x):
    return torch.nn.functional.silu(x)
def _sigmoid(x):
    return torch.sigmoid(x)
def _layernorm(x, axis=-1, eps=1e-5):
    m = x.mean(dim=axis, keepdim=True)
    v = x.var(dim=axis, keepdim=True, unbiased=False)
    return (x - m) / torch.sqrt(v + eps)
def _scatter_add(tgt, idx, src, axis=0):
    return tgt.clone().index_add_(axis, idx, src)
def _segment_sum(src, seg, n):
    out = torch.zeros((n,) + src.shape[1:], dtype=src.dtype)
    return out.index_add_(0, seg, src)
def _pad(x, pw):
    flat = tuple(v for pair in reversed(pw) for v in pair)
    return torch.nn.functional.pad(x, flat)

kernel_name = 'recurrent_scan__sliding_block_cached__dense_activation_squared_relu__decode'

def setup_inputs():

    _w = (lambda a: (lambda t: t.to(torch.bfloat16) if t.is_floating_point() else t)(torch.as_tensor(a)))
    def _A_setup():
        B, Sq, D = 2, 1, 512
        Hq, Hkv, Sk, Dh = 32, 32, 4096, 128
        assert Hq % Hkv == 0, (Hq, Hkv)
        return {
            "x": _w((lambda *s: torch.randn(*s, dtype=torch.bfloat16) * 0.05)(B, Sq, D)),
            "k_cache": _w((lambda *s: torch.randn(*s, dtype=torch.bfloat16) * 0.8)(B, Hkv, Sk, Dh)),
            "v_cache": _w((lambda *s: torch.randn(*s, dtype=torch.bfloat16) * 0.2)(B, Hkv, Sk, Dh)),
            "wq": _w((lambda *s: torch.randn(*s, dtype=torch.bfloat16) * 0.8)(D, Hq * Dh) * (D ** -0.5)),
            "wo": _w((lambda *s: torch.randn(*s, dtype=torch.bfloat16) * 0.2)(Hq * Dh, D) * ((Hq * Dh) ** -0.5)),
        }
    _A_in = _A_setup()

    def _B_setup():
        B, S, D, F = 2, 1, 512, 1376
        return {
            "x": _w((lambda *s: torch.randn(*s, dtype=torch.bfloat16) * 0.05)(B, S, D)),
            "w1": _w((lambda *s: torch.randn(*s, dtype=torch.bfloat16) * 0.1)(D, F)),
            "b1": _w((lambda *s: torch.randn(*s, dtype=torch.bfloat16) * 0.8)(F)),
            "w2": _w((lambda *s: torch.randn(*s, dtype=torch.bfloat16) * 0.1)(F, D)),
            "b2": _w((lambda *s: torch.randn(*s, dtype=torch.bfloat16) * 6.4)(D)),
        }
    _B_in = _B_setup()

    return {
        "A_x": _A_in["x"],
        "A_k_cache": _A_in["k_cache"],
        "A_v_cache": _A_in["v_cache"],
        "A_wq": _A_in["wq"],
        "A_wo": _A_in["wo"],
        "B_x": _B_in["x"],
        "B_w1": _B_in["w1"],
        "B_b1": _B_in["b1"],
        "B_w2": _B_in["w2"],
        "B_b2": _B_in["b2"],
    }

def reference(A_x, A_k_cache, A_v_cache, A_wq, A_wo, B_x, B_w1, B_b1, B_w2, B_b2):
    def _A_ref(x, k_cache, v_cache, wq, wo):
        B, Sq, D = x.shape
        Hq, Dh = 32, 128
        Hkv, Sk = k_cache.shape[1], k_cache.shape[2]
        W = min(4096, max(256, Sk // 4))
        rep = Hq // Hkv
        q = (lambda x, *d: x.permute(*d))((x @ wq).reshape(B, Sq, Hq, Dh), 0, 2, 1, 3)
        k = (lambda x, n, axis: torch.repeat_interleave(x, n, dim=axis))(k_cache[:, :, Sk - W:, :], rep, axis=1)
        v = (lambda x, n, axis: torch.repeat_interleave(x, n, dim=axis))(v_cache[:, :, Sk - W:, :], rep, axis=1)
        scores = torch.einsum("bhqd,bhkd->bhqk", q, k) * (Dh ** -0.5)
        p = _softmax(scores, axis=-1)
        o = torch.einsum("bhqk,bhkd->bhqd", p, v)
        return (lambda x, *d: x.permute(*d))(o, 0, 2, 1, 3).reshape(B, Sq, Hq * Dh) @ wo

    def _B_ref(x, w1, b1, w2, b2):
        h = torch.einsum("bsd,df->bsf", x, w1) + b1
        zero = torch.zeros_like(h)
        r = torch.where(h > zero, h, zero)
        h = r * r
        out = torch.einsum("bsf,fd->bsd", h, w2) + b2
        return out

    x = A_x
    xn = _layernorm(x, axis=-1)
    s = _A_ref(xn, A_k_cache, A_v_cache, A_wq, A_wo)
    g = _silu(_B_ref(xn, B_w1, B_b1, B_w2, B_b2))
    return x + s * g
```

```asm
; @launch grid=(256,1,1) block=(512,1,1) lds=6656
.amdgcn_target "amdgcn-amd-amdhsa--gfx950"
.text
.globl recurrent_scan__sliding_block_cached__dense_activation_squared_relu__decode_kernel
.p2align 8
.type recurrent_scan__sliding_block_cached__dense_activation_squared_relu__decode_kernel,@function
recurrent_scan__sliding_block_cached__dense_activation_squared_relu__decode_kernel:
    s_load_dwordx16 s[16:31], s[0:1], 0
    s_load_dwordx8 s[32:39], s[0:1], 64
    s_load_dwordx2 s[40:41], s[0:1], 96
    v_lshrrev_b32 v1, 6, v0
    v_and_b32 v0, 63, v0
    s_cmp_ge_u32 s2, 256
    v_readfirstlane_b32 s3, v1
    s_cbranch_scc1 L_exit
    s_and_b32 s49, s2, 7
    s_lshr_b32 s50, s2, 6
    s_lshl2_add_u32 s4, s49, s50
    s_bfe_u32 s5, s2, 0x30003
    s_lshr_b32 s6, s5, 2
    v_lshrrev_b32 v3, 4, v0
    v_lshlrev_b32 v191, 4, v0
    v_mov_b32 v4, 0
    s_mov_b32 s47, 0x20000
    s_cmp_ge_u32 s3, 4
    s_cbranch_scc1 L_P
    s_and_b32 s7, s5, 3
    s_lshl2_add_u32 s98, s7, s3
    v_lshlrev_b32 v6, 2, v0
    s_lshl_b32 s48, s6, 5
    s_add_u32 s48, s48, s4
    s_lshl_b32 s48, s48, 6
    s_add_u32 s48, s48, s98
    v_bfe_u32 v190, v0, 2, 2
    v_lshlrev_b32 v190, 8, v190
    s_lshl_b32 s48, s48, 14
    s_add_u32 s48, s48, 0xC0000
    ds_write_b32 v6, v4
    v_lshl_add_u32 v190, v3, 6, v190
    v_and_b32 v184, 3, v0
    v_lshl_add_u32 v190, v184, 4, v190
    s_lshl2_add_u32 s99, s98, s98
    s_lshl1_add_u32 s52, s4, s4
    s_add_u32 s99, s99, s52
    s_lshl3_add_u32 s99, s6, s99
    s_lshl_b32 s99, s99, 10
    s_and_b32 s99, s99, 0x3fff
    s_movk_i32 s46, 0x4000
    s_movk_i32 s54, 0x4000
    s_mov_b32 s55, 0x20000
    s_waitcnt lgkmcnt(0)
    s_add_u32 s52, s20, s48
    s_addc_u32 s53, s21, 0
    buffer_load_dwordx4 v[132:135], v191, s[52:55], s99 offen nt
    s_add_u32 s44, s18, s48
    s_addc_u32 s45, s19, 0
    s_addk_i32 s99, 0x400
    s_and_b32 s99, s99, 0x3fff
    buffer_load_dwordx4 v[8:11], v190, s[44:47], s99 offen nt
    s_addk_i32 s99, 0x400
    s_and_b32 s99, s99, 0x3fff
    s_load_dword s11, s[40:41], 0
    s_barrier
    s_branch L_S2
L_P:
    v_and_b32 v2, 15, v0
    v_bfe_u32 v186, v0, 3, 1
    v_and_b32 v187, 7, v0
    v_mov_b32 v5, 1
    s_cmp_eq_u32 s3, 4
    s_cbranch_scc1 L_P0
    s_getpc_b64 s[58:59]
L_pc:
    v_mul_u32_u24 v180, 0xc00, v1
    v_lshl_add_u32 v180, v0, 7, v180
    v_add_u32 v180, 4294951936, v180
    v_min_u32 v180, L_last-L_pc, v180
    s_mov_b32 exec_lo, 0xffffff
    s_mov_b32 exec_hi, 0
    global_load_dword v194, v180, s[58:59]
    s_mov_b64 exec, -1
    s_waitcnt lgkmcnt(0)
    s_load_dword s11, s[40:41], 0
    s_barrier
    s_branch L_P123
L_P0:
    s_lshl_b32 s56, s5, 19
    s_lshl_b32 s54, s4, 8
    s_add_u32 s56, s56, s54
    s_lshl_b32 s57, s50, 15
    s_lshl_b32 s53, s5, 7
    s_mov_b32 s46, 0x400000
    s_lshl_b32 s52, s50, 3
    v_lshl_add_u32 v180, v3, 3, v187
    v_lshlrev_b32 v180, 5, v180
    v_lshl_add_u32 v180, v186, 10, v180
    v_lshlrev_b32 v181, 5, v3
    v_lshl_add_u32 v181, v186, 10, v181
    v_add_u32 v181, s53, v181
    v_lshlrev_b32 v183, 4, v2
    v_lshl_add_u32 v182, v3, 17, v183
    v_add_u32 v182, s56, v182
    v_add_u32 v200, s52, v181
    s_add_u32 s52, s52, 8
    s_and_b32 s52, s52, 31
    v_add_u32 v201, s52, v181
    s_add_u32 s52, s52, 8
    s_and_b32 s52, s52, 31
    v_add_u32 v202, s52, v181
    s_add_u32 s52, s52, 8
    s_and_b32 s52, s52, 31
    v_add_u32 v203, s52, v181
    s_waitcnt lgkmcnt(0)
    s_mov_b64 s[44:45], s[22:23]
    global_load_dwordx4 v[136:139], v180, s[16:17]
    global_load_dwordx4 v[140:143], v180, s[16:17] offset:16
    global_load_dwordx2 v[144:145], v200, s[16:17]
    global_load_dwordx2 v[146:147], v201, s[16:17]
    global_load_dwordx2 v[148:149], v202, s[16:17]
    global_load_dwordx2 v[150:151], v203, s[16:17]
    s_load_dword s11, s[40:41], 0
    s_barrier
    buffer_load_dwordx4 v[8:11], v182, s[44:47], s57 offen nt
    s_add_u32 s57, s57, 0x2000
    buffer_load_dwordx4 v[12:15], v182, s[44:47], s57 offen nt
    s_add_u32 s57, s57, 0x2000
    buffer_load_dwordx4 v[16:19], v182, s[44:47], s57 offen nt
    s_add_u32 s57, s57, 0x2000
    buffer_load_dwordx4 v[20:23], v182, s[44:47], s57 offen nt
    s_add_u32 s57, s57, 0x2000
    s_and_b32 s57, s57, 0x1ffff
    buffer_load_dwordx4 v[24:27], v182, s[44:47], s57 offen nt
    s_add_u32 s57, s57, 0x2000
    buffer_load_dwordx4 v[28:31], v182, s[44:47], s57 offen nt
    s_add_u32 s57, s57, 0x2000
    buffer_load_dwordx4 v[32:35], v182, s[44:47], s57 offen nt
    s_add_u32 s57, s57, 0x2000
    buffer_load_dwordx4 v[36:39], v182, s[44:47], s57 offen nt
    s_add_u32 s57, s57, 0x2000
    s_and_b32 s57, s57, 0x1ffff
    buffer_load_dwordx4 v[40:43], v182, s[44:47], s57 offen nt
    s_add_u32 s57, s57, 0x2000
    buffer_load_dwordx4 v[44:47], v182, s[44:47], s57 offen nt
    s_add_u32 s57, s57, 0x2000
    buffer_load_dwordx4 v[48:51], v182, s[44:47], s57 offen nt
    s_add_u32 s57, s57, 0x2000
    buffer_load_dwordx4 v[52:55], v182, s[44:47], s57 offen nt
    s_add_u32 s57, s57, 0x2000
    s_and_b32 s57, s57, 0x1ffff
    buffer_load_dwordx4 v[56:59], v182, s[44:47], s57 offen nt
    s_add_u32 s57, s57, 0x2000
    buffer_load_dwordx4 v[60:63], v182, s[44:47], s57 offen nt
    s_add_u32 s57, s57, 0x2000
    buffer_load_dwordx4 v[64:67], v182, s[44:47], s57 offen nt
    s_add_u32 s57, s57, 0x2000
    buffer_load_dwordx4 v[68:71], v182, s[44:47], s57 offen nt
    s_branch L_tile2
L_S2:
    v_and_b32 v2, 15, v0
    v_mov_b32 v5, 1
    v_lshl_add_u32 v180, v3, 2, v184
    v_lshlrev_b32 v183, 4, v180
    v_mov_b32 v136, 0
    v_mov_b32 v137, 0
    v_mov_b32 v138, 0
    v_mov_b32 v139, 0
    v_mov_b32 v140, 0
    v_mov_b32 v141, 0
    v_mov_b32 v142, 0
    v_mov_b32 v143, 0
    v_mov_b32 v144, 0
    v_mov_b32 v145, 0
    v_mov_b32 v146, 0
    v_mov_b32 v147, 0
    v_mov_b32 v148, 0
    v_mov_b32 v149, 0
    v_mov_b32 v150, 0
    v_mov_b32 v151, 0
    s_and_b32 s8, s5, 1
    s_lshr_b32 s9, s5, 1
    s_lshl1_add_u32 s10, s4, s8
    v_and_b32 v180, 1, v0
    v_lshlrev_b32 v180, 4, v180
    v_mov_b32 v181, 0xffff
    v_lshlrev_b32 v180, v180, v181
    v_bfe_u32 v181, v0, 1, 2
    v_cmp_eq_u32 s[80:81], 0, v181
    v_cmp_eq_u32 s[82:83], 1, v181
    v_cmp_eq_u32 s[84:85], 2, v181
    v_cmp_eq_u32 s[86:87], 3, v181
    v_mov_b32 v185, 0xff
    s_add_u32 s62, s40, 2097152
    s_addc_u32 s63, s41, 0
    v_cndmask_b32 v172, 0, v180, s[80:81]
    v_cndmask_b32 v173, 0, v180, s[82:83]
    v_cndmask_b32 v174, 0, v180, s[84:85]
    v_cndmask_b32 v175, 0, v180, s[86:87]
    s_lshl_b32 s57, s6, 4
    s_add_u32 s57, s57, s98
    s_lshl_b32 s57, s57, 6
    s_lshl_b32 s51, s4, 14
    s_add_u32 s57, s57, s51
    s_add_u32 s57, s57, 524288
    v_lshrrev_b32 v188, 1, v2
    v_lshlrev_b32 v188, 11, v188
    v_and_b32 v180, 1, v2
    v_lshl_add_u32 v188, v180, 5, v188
    v_and_b32 v180, 1, v3
    v_lshl_add_u32 v188, v180, 4, v188
    v_add_u32 v188, s57, v188
    s_waitcnt vmcnt(1)
    buffer_load_dwordx4 v[12:15], v190, s[44:47], s99 offen nt
    s_addk_i32 s99, 0x400
    s_and_b32 s99, s99, 0x3fff
    s_waitcnt vmcnt(1)
    buffer_load_dwordx4 v[16:19], v190, s[44:47], s99 offen nt
    s_addk_i32 s99, 0x400
    s_and_b32 s99, s99, 0x3fff
    s_waitcnt vmcnt(1)
    buffer_load_dwordx4 v[20:23], v190, s[44:47], s99 offen nt
    s_addk_i32 s99, 0x400
    s_and_b32 s99, s99, 0x3fff
    buffer_load_dwordx4 v[24:27], v190, s[44:47], s99 offen nt
    s_addk_i32 s99, 0x400
    s_and_b32 s99, s99, 0x3fff
    s_waitcnt vmcnt(5)
    buffer_load_dwordx4 v[28:31], v190, s[44:47], s99 offen nt
    s_addk_i32 s99, 0x400
    s_and_b32 s99, s99, 0x3fff
    s_waitcnt vmcnt(5)
    buffer_load_dwordx4 v[32:35], v190, s[44:47], s99 offen nt
    s_addk_i32 s99, 0x400
    s_and_b32 s99, s99, 0x3fff
    s_waitcnt vmcnt(5)
    buffer_load_dwordx4 v[36:39], v190, s[44:47], s99 offen nt
    s_addk_i32 s99, 0x400
    s_and_b32 s99, s99, 0x3fff
    s_waitcnt vmcnt(5)
    buffer_load_dwordx4 v[40:43], v190, s[44:47], s99 offen nt
    s_addk_i32 s99, 0x400
    s_and_b32 s99, s99, 0x3fff
    s_waitcnt vmcnt(5)
    buffer_load_dwordx4 v[44:47], v190, s[44:47], s99 offen nt
    s_addk_i32 s99, 0x400
    s_and_b32 s99, s99, 0x3fff
    s_waitcnt vmcnt(5)
    buffer_load_dwordx4 v[48:51], v190, s[44:47], s99 offen nt
    s_addk_i32 s99, 0x400
    s_and_b32 s99, s99, 0x3fff
    s_waitcnt vmcnt(5)
    buffer_load_dwordx4 v[52:55], v190, s[44:47], s99 offen nt
    s_addk_i32 s99, 0x400
    s_and_b32 s99, s99, 0x3fff
    s_mov_b64 exec, 1
    ds_add_u32 v4, v5 offset:16
    s_mov_b64 exec, -1
    s_waitcnt vmcnt(5)
    buffer_load_dwordx4 v[56:59], v190, s[44:47], s99 offen nt
    s_addk_i32 s99, 0x400
    s_and_b32 s99, s99, 0x3fff
    s_waitcnt vmcnt(5)
    buffer_load_dwordx4 v[60:63], v190, s[44:47], s99 offen nt
    s_addk_i32 s99, 0x400
    s_and_b32 s99, s99, 0x3fff
    s_waitcnt vmcnt(5)
    buffer_load_dwordx4 v[64:67], v190, s[44:47], s99 offen nt
    s_addk_i32 s99, 0x400
    s_and_b32 s99, s99, 0x3fff
    s_waitcnt vmcnt(5)
    buffer_load_dwordx4 v[68:71], v190, s[44:47], s99 offen nt
    s_addk_i32 s99, 0x400
    s_and_b32 s99, s99, 0x3fff
    s_waitcnt vmcnt(5)
    buffer_load_dwordx4 v[72:75], v191, s[52:55], s99 offen nt
    s_addk_i32 s99, 0x400
    s_and_b32 s99, s99, 0x3fff
    s_waitcnt vmcnt(5)
    buffer_load_dwordx4 v[76:79], v191, s[52:55], s99 offen nt
    s_addk_i32 s99, 0x400
    s_and_b32 s99, s99, 0x3fff
    s_waitcnt vmcnt(5)
    buffer_load_dwordx4 v[80:83], v191, s[52:55], s99 offen nt
    s_addk_i32 s99, 0x400
    s_and_b32 s99, s99, 0x3fff
    s_waitcnt vmcnt(5)
    buffer_load_dwordx4 v[84:87], v191, s[52:55], s99 offen nt
    s_addk_i32 s99, 0x400
    s_and_b32 s99, s99, 0x3fff
    s_waitcnt vmcnt(5)
    buffer_load_dwordx4 v[88:91], v191, s[52:55], s99 offen nt
    s_addk_i32 s99, 0x400
    s_and_b32 s99, s99, 0x3fff
    s_waitcnt vmcnt(5)
    buffer_load_dwordx4 v[92:95], v191, s[52:55], s99 offen nt
    s_addk_i32 s99, 0x400
    s_and_b32 s99, s99, 0x3fff
    s_waitcnt vmcnt(5)
    buffer_load_dwordx4 v[96:99], v191, s[52:55], s99 offen nt
    s_addk_i32 s99, 0x400
    s_and_b32 s99, s99, 0x3fff
    s_waitcnt vmcnt(5)
    buffer_load_dwordx4 v[100:103], v191, s[52:55], s99 offen nt
    s_addk_i32 s99, 0x400
    s_and_b32 s99, s99, 0x3fff
    s_getreg_b32 s96, hwreg(HW_REG_XCC_ID, 0, 4)
    s_waitcnt lgkmcnt(0)
    s_mul_i32 s97, s11, 0x9E3779B1
    s_add_u32 s97, s97, 0x7F4A7C15
    s_lshl_b32 s97, s97, 6
    s_or_b32 s97, s97, 32
    s_or_b32 s96, s96, s97
    s_or_b32 s97, s97, 16
    s_and_b32 s92, s96, 0xff
    s_bfe_u32 s93, s96, 0x80008
    s_bfe_u32 s94, s96, 0x80010
    s_lshr_b32 s95, s96, 24
    s_and_b32 s84, s97, 0xff
    s_bfe_u32 s85, s97, 0x80008
    s_bfe_u32 s86, s97, 0x80010
    s_lshr_b32 s87, s97, 24
    s_mov_b32 s43, 0x40000
    s_branch L_sq_in
L_sq:
    s_sleep 1
L_sq_in:
    ds_read_b32 v180, v4 offset:0
    s_sub_u32 s43, s43, 1
    s_cbranch_scc1 L_end
    s_waitcnt lgkmcnt(0)
    v_cmp_gt_u32 vcc, 4, v180
    s_cbranch_vccnz L_sq
    s_mov_b32 exec_lo, 0x000f000f
    s_mov_b32 exec_hi, exec_lo
    ds_read_b128 v[136:139], v183 offset:64
    s_mov_b32 exec_lo, 0x00f000f0
    s_mov_b32 exec_hi, exec_lo
    ds_read_b128 v[140:143], v183 offset:64
    s_mov_b32 exec_lo, 0x0f000f00
    s_mov_b32 exec_hi, exec_lo
    ds_read_b128 v[144:147], v183 offset:64
    s_mov_b32 exec_lo, 0xf000f000
    s_mov_b32 exec_hi, exec_lo
    ds_read_b128 v[148:151], v183 offset:64
    s_mov_b64 exec, -1
    s_waitcnt vmcnt(8) lgkmcnt(3)
    v_mfma_f32_16x16x32_bf16 v[152:155], v[8:11], v[136:139], 0
    v_mfma_f32_16x16x32_bf16 v[156:159], v[24:27], v[136:139], 0
    v_mfma_f32_16x16x32_bf16 v[160:163], v[40:43], v[136:139], 0
    v_mfma_f32_16x16x32_bf16 v[164:167], v[56:59], v[136:139], 0
    s_waitcnt vmcnt(8) lgkmcnt(2)
    v_mfma_f32_16x16x32_bf16 v[152:155], v[12:15], v[140:143], v[152:155]
    v_mfma_f32_16x16x32_bf16 v[156:159], v[28:31], v[140:143], v[156:159]
    v_mfma_f32_16x16x32_bf16 v[160:163], v[44:47], v[140:143], v[160:163]
    v_mfma_f32_16x16x32_bf16 v[164:167], v[60:63], v[140:143], v[164:167]
    s_waitcnt vmcnt(8) lgkmcnt(1)
    v_mfma_f32_16x16x32_bf16 v[152:155], v[16:19], v[144:147], v[152:155]
    v_mfma_f32_16x16x32_bf16 v[156:159], v[32:35], v[144:147], v[156:159]
    v_mfma_f32_16x16x32_bf16 v[160:163], v[48:51], v[144:147], v[160:163]
    v_mfma_f32_16x16x32_bf16 v[164:167], v[64:67], v[144:147], v[164:167]
    s_waitcnt vmcnt(8) lgkmcnt(0)
    v_mfma_f32_16x16x32_bf16 v[152:155], v[20:23], v[148:151], v[152:155]
    v_mfma_f32_16x16x32_bf16 v[156:159], v[36:39], v[148:151], v[156:159]
    v_mfma_f32_16x16x32_bf16 v[160:163], v[52:55], v[148:151], v[160:163]
    v_mfma_f32_16x16x32_bf16 v[164:167], v[68:71], v[148:151], v[164:167]
    s_waitcnt vmcnt(5)
    buffer_load_dwordx4 v[104:107], v191, s[52:55], s99 offen nt
    s_addk_i32 s99, 0x400
    s_and_b32 s99, s99, 0x3fff
    s_nop 0
    v_mov_b32_dpp v168, v152 quad_perm:[0,0,0,0] row_mask:0xf bank_mask:0xf
    v_mov_b32_dpp v169, v156 quad_perm:[0,0,0,0] row_mask:0xf bank_mask:0xf
    v_mov_b32_dpp v170, v160 quad_perm:[0,0,0,0] row_mask:0xf bank_mask:0xf
    v_mov_b32_dpp v171, v164 quad_perm:[0,0,0,0] row_mask:0xf bank_mask:0xf
    v_add_f32_dpp v168, v153, v168 quad_perm:[1,1,1,1] row_mask:0xf bank_mask:0xf
    v_add_f32_dpp v169, v157, v169 quad_perm:[1,1,1,1] row_mask:0xf bank_mask:0xf
    v_add_f32_dpp v170, v161, v170 quad_perm:[1,1,1,1] row_mask:0xf bank_mask:0xf
    v_add_f32_dpp v171, v165, v171 quad_perm:[1,1,1,1] row_mask:0xf bank_mask:0xf
    v_add_f32_dpp v168, v154, v168 quad_perm:[2,2,2,2] row_mask:0xf bank_mask:0xf
    v_add_f32_dpp v169, v158, v169 quad_perm:[2,2,2,2] row_mask:0xf bank_mask:0xf
    v_add_f32_dpp v170, v162, v170 quad_perm:[2,2,2,2] row_mask:0xf bank_mask:0xf
    v_add_f32_dpp v171, v166, v171 quad_perm:[2,2,2,2] row_mask:0xf bank_mask:0xf
    v_add_f32_dpp v168, v155, v168 quad_perm:[3,3,3,3] row_mask:0xf bank_mask:0xf
    v_add_f32_dpp v169, v159, v169 quad_perm:[3,3,3,3] row_mask:0xf bank_mask:0xf
    v_add_f32_dpp v170, v163, v170 quad_perm:[3,3,3,3] row_mask:0xf bank_mask:0xf
    v_add_f32_dpp v171, v167, v171 quad_perm:[3,3,3,3] row_mask:0xf bank_mask:0xf
    v_max3_f32 v152, v168, v169, v170
    v_max_f32 v152, v152, v171
    s_mov_b32 s48, 0x3e0293ee
    v_mov_b32 v155, s96
    v_max_f32_dpp v152, v152, v152 row_ror:4 row_mask:0xf bank_mask:0xf
    s_nop 1
    v_max_f32_dpp v152, v152, v152 row_ror:8 row_mask:0xf bank_mask:0xf
    v_mov_b32 v180, v152
    s_nop 1
    v_permlane16_swap_b32 v152, v180
    v_max_f32 v152, v152, v180
    v_mov_b32 v180, v152
    s_nop 1
    v_permlane32_swap_b32 v152, v180
    v_max_f32 v152, v152, v180
    v_mul_f32 v152, s48, v152
    v_fma_f32 v168, v168, s48, -v152
    v_fma_f32 v169, v169, s48, -v152
    v_fma_f32 v170, v170, s48, -v152
    v_fma_f32 v171, v171, s48, -v152
    v_exp_f32 v168, v168
    v_exp_f32 v169, v169
    v_exp_f32 v170, v170
    v_exp_f32 v171, v171
    v_add_f32 v153, v168, v169
    v_add_f32 v180, v170, v171
    v_add_f32 v153, v153, v180
    s_nop 1
    v_add_f32_dpp v153, v153, v153 row_ror:4 row_mask:0xf bank_mask:0xf
    s_nop 1
    v_add_f32_dpp v153, v153, v153 row_ror:8 row_mask:0xf bank_mask:0xf
    v_mov_b32 v180, v153
    s_nop 1
    v_permlane16_swap_b32 v153, v180
    v_add_f32 v153, v153, v180
    v_mov_b32 v180, v153
    s_nop 1
    v_permlane32_swap_b32 v153, v180
    v_add_f32 v153, v153, v180
    v_rcp_f32 v198, v153
    v_log_f32 v180, v153
    v_mul_f32 v168, v168, v198
    v_mul_f32 v169, v169, v198
    v_mul_f32 v170, v170, v198
    v_mul_f32 v171, v171, v198
    v_add_f32 v154, v152, v180
    v_cvt_pk_bf16_f32 v168, v168, v168
    v_cvt_pk_bf16_f32 v169, v169, v169
    v_cvt_pk_bf16_f32 v170, v170, v170
    v_cvt_pk_bf16_f32 v171, v171, v171
    s_waitcnt vmcnt(5)
    buffer_load_dwordx4 v[108:111], v191, s[52:55], s99 offen nt
    s_addk_i32 s99, 0x400
    s_and_b32 s99, s99, 0x3fff
    v_and_b32_dpp v8, v168, v172 row_newbcast:0 row_mask:0xf bank_mask:0xf
    v_and_b32_dpp v9, v168, v173 row_newbcast:0 row_mask:0xf bank_mask:0xf
    v_and_b32_dpp v10, v168, v174 row_newbcast:0 row_mask:0xf bank_mask:0xf
    v_and_b32_dpp v11, v168, v175 row_newbcast:0 row_mask:0xf bank_mask:0xf
    v_and_b32_dpp v12, v168, v172 row_newbcast:4 row_mask:0xf bank_mask:0xf
    v_and_b32_dpp v13, v168, v173 row_newbcast:4 row_mask:0xf bank_mask:0xf
    v_and_b32_dpp v14, v168, v174 row_newbcast:4 row_mask:0xf bank_mask:0xf
    v_and_b32_dpp v15, v168, v175 row_newbcast:4 row_mask:0xf bank_mask:0xf
    v_and_b32_dpp v16, v168, v172 row_newbcast:8 row_mask:0xf bank_mask:0xf
    v_and_b32_dpp v17, v168, v173 row_newbcast:8 row_mask:0xf bank_mask:0xf
    v_and_b32_dpp v18, v168, v174 row_newbcast:8 row_mask:0xf bank_mask:0xf
    v_and_b32_dpp v19, v168, v175 row_newbcast:8 row_mask:0xf bank_mask:0xf
    v_and_b32_dpp v20, v168, v172 row_newbcast:12 row_mask:0xf bank_mask:0xf
    v_and_b32_dpp v21, v168, v173 row_newbcast:12 row_mask:0xf bank_mask:0xf
    v_and_b32_dpp v22, v168, v174 row_newbcast:12 row_mask:0xf bank_mask:0xf
    v_and_b32_dpp v23, v168, v175 row_newbcast:12 row_mask:0xf bank_mask:0xf
    v_and_b32_dpp v24, v169, v172 row_newbcast:0 row_mask:0xf bank_mask:0xf
    v_and_b32_dpp v25, v169, v173 row_newbcast:0 row_mask:0xf bank_mask:0xf
    v_and_b32_dpp v26, v169, v174 row_newbcast:0 row_mask:0xf bank_mask:0xf
    v_and_b32_dpp v27, v169, v175 row_newbcast:0 row_mask:0xf bank_mask:0xf
    v_and_b32_dpp v28, v169, v172 row_newbcast:4 row_mask:0xf bank_mask:0xf
    v_and_b32_dpp v29, v169, v173 row_newbcast:4 row_mask:0xf bank_mask:0xf
    v_and_b32_dpp v30, v169, v174 row_newbcast:4 row_mask:0xf bank_mask:0xf
    v_and_b32_dpp v31, v169, v175 row_newbcast:4 row_mask:0xf bank_mask:0xf
    v_and_b32_dpp v32, v169, v172 row_newbcast:8 row_mask:0xf bank_mask:0xf
    v_and_b32_dpp v33, v169, v173 row_newbcast:8 row_mask:0xf bank_mask:0xf
    v_and_b32_dpp v34, v169, v174 row_newbcast:8 row_mask:0xf bank_mask:0xf
    v_and_b32_dpp v35, v169, v175 row_newbcast:8 row_mask:0xf bank_mask:0xf
    v_and_b32_dpp v36, v169, v172 row_newbcast:12 row_mask:0xf bank_mask:0xf
    v_and_b32_dpp v37, v169, v173 row_newbcast:12 row_mask:0xf bank_mask:0xf
    v_and_b32_dpp v38, v169, v174 row_newbcast:12 row_mask:0xf bank_mask:0xf
    v_and_b32_dpp v39, v169, v175 row_newbcast:12 row_mask:0xf bank_mask:0xf
    s_waitcnt vmcnt(9)
    buffer_load_dwordx4 v[112:115], v191, s[52:55], s99 offen nt
    s_addk_i32 s99, 0x400
    s_and_b32 s99, s99, 0x3fff
    v_and_b32_dpp v40, v170, v172 row_newbcast:0 row_mask:0xf bank_mask:0xf
    v_and_b32_dpp v41, v170, v173 row_newbcast:0 row_mask:0xf bank_mask:0xf
    v_and_b32_dpp v42, v170, v174 row_newbcast:0 row_mask:0xf bank_mask:0xf
    v_and_b32_dpp v43, v170, v175 row_newbcast:0 row_mask:0xf bank_mask:0xf
    v_and_b32_dpp v44, v170, v172 row_newbcast:4 row_mask:0xf bank_mask:0xf
    v_and_b32_dpp v45, v170, v173 row_newbcast:4 row_mask:0xf bank_mask:0xf
    v_and_b32_dpp v46, v170, v174 row_newbcast:4 row_mask:0xf bank_mask:0xf
    v_and_b32_dpp v47, v170, v175 row_newbcast:4 row_mask:0xf bank_mask:0xf
    v_and_b32_dpp v48, v170, v172 row_newbcast:8 row_mask:0xf bank_mask:0xf
    v_and_b32_dpp v49, v170, v173 row_newbcast:8 row_mask:0xf bank_mask:0xf
    v_and_b32_dpp v50, v170, v174 row_newbcast:8 row_mask:0xf bank_mask:0xf
    v_and_b32_dpp v51, v170, v175 row_newbcast:8 row_mask:0xf bank_mask:0xf
    v_and_b32_dpp v52, v170, v172 row_newbcast:12 row_mask:0xf bank_mask:0xf
    v_and_b32_dpp v53, v170, v173 row_newbcast:12 row_mask:0xf bank_mask:0xf
    v_and_b32_dpp v54, v170, v174 row_newbcast:12 row_mask:0xf bank_mask:0xf
    v_and_b32_dpp v55, v170, v175 row_newbcast:12 row_mask:0xf bank_mask:0xf
    v_and_b32_dpp v56, v171, v172 row_newbcast:0 row_mask:0xf bank_mask:0xf
    v_and_b32_dpp v57, v171, v173 row_newbcast:0 row_mask:0xf bank_mask:0xf
    v_and_b32_dpp v58, v171, v174 row_newbcast:0 row_mask:0xf bank_mask:0xf
    v_and_b32_dpp v59, v171, v175 row_newbcast:0 row_mask:0xf bank_mask:0xf
    v_and_b32_dpp v60, v171, v172 row_newbcast:4 row_mask:0xf bank_mask:0xf
    v_and_b32_dpp v61, v171, v173 row_newbcast:4 row_mask:0xf bank_mask:0xf
    v_and_b32_dpp v62, v171, v174 row_newbcast:4 row_mask:0xf bank_mask:0xf
    v_and_b32_dpp v63, v171, v175 row_newbcast:4 row_mask:0xf bank_mask:0xf
    v_and_b32_dpp v64, v171, v172 row_newbcast:8 row_mask:0xf bank_mask:0xf
    v_and_b32_dpp v65, v171, v173 row_newbcast:8 row_mask:0xf bank_mask:0xf
    v_and_b32_dpp v66, v171, v174 row_newbcast:8 row_mask:0xf bank_mask:0xf
    v_and_b32_dpp v67, v171, v175 row_newbcast:8 row_mask:0xf bank_mask:0xf
    v_and_b32_dpp v68, v171, v172 row_newbcast:12 row_mask:0xf bank_mask:0xf
    v_and_b32_dpp v69, v171, v173 row_newbcast:12 row_mask:0xf bank_mask:0xf
    v_and_b32_dpp v70, v171, v174 row_newbcast:12 row_mask:0xf bank_mask:0xf
    v_and_b32_dpp v71, v171, v175 row_newbcast:12 row_mask:0xf bank_mask:0xf
    s_waitcnt vmcnt(9)
    buffer_load_dwordx4 v[116:119], v191, s[52:55], s99 offen nt
    s_addk_i32 s99, 0x400
    s_and_b32 s99, s99, 0x3fff
    s_waitcnt vmcnt(9)
    buffer_load_dwordx4 v[120:123], v191, s[52:55], s99 offen nt
    s_addk_i32 s99, 0x400
    s_and_b32 s99, s99, 0x3fff
    s_waitcnt vmcnt(9)
    buffer_load_dwordx4 v[124:127], v191, s[52:55], s99 offen nt
    s_addk_i32 s99, 0x400
    s_and_b32 s99, s99, 0x3fff
    s_waitcnt vmcnt(9)
    buffer_load_dwordx4 v[128:131], v191, s[52:55], s99 offen nt
    s_mov_b64 exec, 1
    ds_add_u32 v4, v5 offset:4
    s_mov_b64 exec, -1
    s_waitcnt vmcnt(15)
    v_mfma_f32_16x16x32_bf16 v[176:179], v[68:71], v[132:135], 0
    s_waitcnt vmcnt(14)
    v_mfma_f32_16x16x32_bf16 v[176:179], v[8:11], v[72:75], v[176:179]
    s_waitcnt vmcnt(13)
    v_mfma_f32_16x16x32_bf16 v[176:179], v[12:15], v[76:79], v[176:179]
    s_waitcnt vmcnt(12)
    v_mfma_f32_16x16x32_bf16 v[176:179], v[16:19], v[80:83], v[176:179]
    s_waitcnt vmcnt(11)
    v_mfma_f32_16x16x32_bf16 v[176:179], v[20:23], v[84:87], v[176:179]
    s_waitcnt vmcnt(10)
    v_mfma_f32_16x16x32_bf16 v[176:179], v[24:27], v[88:91], v[176:179]
    s_waitcnt vmcnt(9)
    v_mfma_f32_16x16x32_bf16 v[176:179], v[28:31], v[92:95], v[176:179]
    s_waitcnt vmcnt(8)
    v_mfma_f32_16x16x32_bf16 v[176:179], v[32:35], v[96:99], v[176:179]
    s_waitcnt vmcnt(7)
    v_mfma_f32_16x16x32_bf16 v[176:179], v[36:39], v[100:103], v[176:179]
    s_waitcnt vmcnt(6)
    v_mfma_f32_16x16x32_bf16 v[176:179], v[40:43], v[104:107], v[176:179]
    s_waitcnt vmcnt(5)
    v_mfma_f32_16x16x32_bf16 v[176:179], v[44:47], v[108:111], v[176:179]
    s_waitcnt vmcnt(4)
    v_mfma_f32_16x16x32_bf16 v[176:179], v[48:51], v[112:115], v[176:179]
    s_waitcnt vmcnt(3)
    v_mfma_f32_16x16x32_bf16 v[176:179], v[52:55], v[116:119], v[176:179]
    s_waitcnt vmcnt(2)
    v_mfma_f32_16x16x32_bf16 v[176:179], v[56:59], v[120:123], v[176:179]
    s_waitcnt vmcnt(1)
    v_mfma_f32_16x16x32_bf16 v[176:179], v[60:63], v[124:127], v[176:179]
    s_waitcnt vmcnt(0)
    v_mfma_f32_16x16x32_bf16 v[176:179], v[64:67], v[128:131], v[176:179]
    s_mov_b32 exec_hi, 0
    s_nop 6
    v_cvt_pk_bf16_f32 v152, v176, v177
    v_cvt_pk_bf16_f32 v153, v178, v179
    global_store_dwordx4 v188, v[152:155], s[62:63]
    s_mov_b64 exec, 1
    ds_add_u32 v4, v5 offset:12
    s_mov_b64 exec, -1
    s_movk_i32 s43, 200
L_sb:
    ds_read_b32 v180, v4 offset:20
    s_sub_u32 s43, s43, 1
    s_cbranch_scc1 L_sb_b
    s_waitcnt lgkmcnt(0)
    v_readfirstlane_b32 s48, v180
    s_nop 0
    s_cmp_eq_u32 s48, 1
    s_cbranch_scc1 L_end
    s_sleep 4
    s_cmp_eq_u32 s48, 0
    s_cbranch_scc1 L_sb
L_sb_b:
    s_mov_b32 exec_hi, 0
    v_mov_b32 v155, s97
    global_store_dwordx4 v188, v[152:155], s[40:41] sc1
    s_branch L_end
L_tile2:
    s_mov_b64 s[88:89], s[28:29]
    s_mov_b32 s90, 1409024
    s_mov_b32 s91, 0x20000
    s_lshl_b32 s52, s5, 4
    s_add_u32 s52, s52, s50
    s_mul_i32 s52, s52, 11008
    s_mul_i32 s53, s49, 352
    s_add_u32 s52, s52, s53
    s_mov_b32 s53, 44032
    v_mad_u32_u24 v182, v3, s53, v183
    v_mov_b32 v183, 0x7f000000
    v_cmp_gt_u32 vcc, 6, v2
    s_nop 1
    v_cndmask_b32 v183, v183, v182, vcc
    s_waitcnt vmcnt(15)
    buffer_load_dwordx4 v[208:211], v182, s[88:91], s52 offen nt
    buffer_load_dwordx4 v[224:227], v183, s[88:91], s52 offen offset:256 nt
    s_addk_i32 s52, 2752
    s_waitcnt vmcnt(15)
    buffer_load_dwordx4 v[212:215], v182, s[88:91], s52 offen nt
    buffer_load_dwordx4 v[228:231], v183, s[88:91], s52 offen offset:256 nt
    s_addk_i32 s52, 2752
    s_waitcnt vmcnt(15)
    buffer_load_dwordx4 v[216:219], v182, s[88:91], s52 offen nt
    buffer_load_dwordx4 v[232:235], v183, s[88:91], s52 offen offset:256 nt
    s_addk_i32 s52, 2752
    s_waitcnt vmcnt(15)
    buffer_load_dwordx4 v[220:223], v182, s[88:91], s52 offen nt
    buffer_load_dwordx4 v[236:239], v183, s[88:91], s52 offen offset:256 nt
    s_and_b32 s8, s5, 1
    s_lshr_b32 s9, s5, 1
    s_lshl1_add_u32 s10, s4, s8
    v_and_b32 v180, 1, v0
    v_lshlrev_b32 v180, 4, v180
    v_mov_b32 v181, 0xffff
    v_lshlrev_b32 v180, v180, v181
    v_bfe_u32 v181, v0, 1, 2
    v_cmp_eq_u32 s[80:81], 0, v181
    v_cmp_eq_u32 s[82:83], 1, v181
    v_cmp_eq_u32 s[84:85], 2, v181
    v_cmp_eq_u32 s[86:87], 3, v181
    v_mov_b32 v185, 0xff
    s_add_u32 s62, s40, 2097152
    s_addc_u32 s63, s41, 0
    v_cndmask_b32 v172, 0, v180, s[80:81]
    v_cndmask_b32 v173, 0, v180, s[82:83]
    v_cndmask_b32 v174, 0, v180, s[84:85]
    v_cndmask_b32 v175, 0, v180, s[86:87]
    v_mov_b32 v182, 0x3f803f80
    s_waitcnt vmcnt(28)
    v_dot2_f32_bf16 v180, v136, v182, 0
    v_dot2_f32_bf16 v181, v136, v136, 0
    v_dot2_f32_bf16 v180, v137, v182, v180
    v_dot2_f32_bf16 v181, v137, v137, v181
    v_dot2_f32_bf16 v180, v138, v182, v180
    v_dot2_f32_bf16 v181, v138, v138, v181
    v_dot2_f32_bf16 v180, v139, v182, v180
    v_dot2_f32_bf16 v181, v139, v139, v181
    v_dot2_f32_bf16 v180, v140, v182, v180
    v_dot2_f32_bf16 v181, v140, v140, v181
    v_dot2_f32_bf16 v180, v141, v182, v180
    v_dot2_f32_bf16 v181, v141, v141, v181
    v_dot2_f32_bf16 v180, v142, v182, v180
    v_dot2_f32_bf16 v181, v142, v142, v181
    v_dot2_f32_bf16 v180, v143, v182, v180
    v_dot2_f32_bf16 v181, v143, v143, v181
    s_waitcnt vmcnt(24)
    v_and_b32 v167, 0xffff0000, v151
    v_lshlrev_b32 v166, 16, v151
    v_add_f32_dpp v180, v180, v180 quad_perm:[1,0,3,2] row_mask:0xf bank_mask:0xf
    v_add_f32_dpp v181, v181, v181 quad_perm:[1,0,3,2] row_mask:0xf bank_mask:0xf
    v_and_b32 v165, 0xffff0000, v150
    v_add_f32_dpp v180, v180, v180 quad_perm:[2,3,0,1] row_mask:0xf bank_mask:0xf
    v_add_f32_dpp v181, v181, v181 quad_perm:[2,3,0,1] row_mask:0xf bank_mask:0xf
    v_lshlrev_b32 v164, 16, v150
    v_add_f32_dpp v180, v180, v180 row_half_mirror row_mask:0xf bank_mask:0xf
    v_add_f32_dpp v181, v181, v181 row_half_mirror row_mask:0xf bank_mask:0xf
    v_and_b32 v163, 0xffff0000, v149
    v_mov_b32 v182, v180
    v_mov_b32 v183, v181
    v_lshlrev_b32 v162, 16, v149
    v_permlane16_swap_b32 v180, v182
    v_permlane16_swap_b32 v181, v183
    v_add_f32 v180, v180, v182
    v_add_f32 v181, v181, v183
    v_mov_b32 v182, v180
    v_mov_b32 v183, v181
    v_and_b32 v161, 0xffff0000, v148
    v_permlane32_swap_b32 v180, v182
    v_permlane32_swap_b32 v181, v183
    v_add_f32 v180, v180, v182
    v_add_f32 v181, v181, v183
    v_mul_f32 v180, 0x3b000000, v180
    v_mul_f32 v182, v180, v180
    s_mov_b32 s56, 0x3b000000
    v_fma_f32 v181, v181, s56, -v182
    v_max_f32 v181, 0, v181
    v_cvt_pk_bf16_f32 v182, v180, v181
    v_lshlrev_b32 v180, 16, v182
    v_and_b32 v181, 0xffff0000, v182
    v_add_f32 v181, 0x3727c5ac, v181
    v_cvt_pk_bf16_f32 v181, v181, v181
    v_lshlrev_b32 v181, 16, v181
    v_sqrt_f32 v181, v181
    v_lshlrev_b32 v160, 16, v148
    v_cvt_pk_bf16_f32 v181, v181, v181
    v_lshlrev_b32 v181, 16, v181
    v_rcp_f32 v181, v181
    v_lshlrev_b32 v152, 16, v144
    v_and_b32 v153, 0xffff0000, v144
    v_lshlrev_b32 v154, 16, v145
    v_and_b32 v155, 0xffff0000, v145
    v_lshlrev_b32 v156, 16, v146
    v_and_b32 v157, 0xffff0000, v146
    v_lshlrev_b32 v158, 16, v147
    v_and_b32 v159, 0xffff0000, v147
    v_mul_f32 v180, v180, v181
    v_fma_f32 v152, v152, v181, -v180
    v_fma_f32 v153, v153, v181, -v180
    v_fma_f32 v154, v154, v181, -v180
    v_fma_f32 v155, v155, v181, -v180
    v_fma_f32 v156, v156, v181, -v180
    v_fma_f32 v157, v157, v181, -v180
    v_fma_f32 v158, v158, v181, -v180
    v_fma_f32 v159, v159, v181, -v180
    v_fma_f32 v160, v160, v181, -v180
    v_fma_f32 v161, v161, v181, -v180
    v_fma_f32 v162, v162, v181, -v180
    v_fma_f32 v163, v163, v181, -v180
    v_fma_f32 v164, v164, v181, -v180
    v_fma_f32 v165, v165, v181, -v180
    v_fma_f32 v166, v166, v181, -v180
    v_fma_f32 v167, v167, v181, -v180
    v_cvt_pk_bf16_f32 v152, v152, v152
    v_cvt_pk_bf16_f32 v153, v153, v153
    v_cvt_pk_bf16_f32 v154, v154, v154
    v_cvt_pk_bf16_f32 v155, v155, v155
    v_cvt_pk_bf16_f32 v156, v156, v156
    v_cvt_pk_bf16_f32 v157, v157, v157
    v_cvt_pk_bf16_f32 v158, v158, v158
    v_cvt_pk_bf16_f32 v159, v159, v159
    v_cvt_pk_bf16_f32 v160, v160, v160
    v_cvt_pk_bf16_f32 v161, v161, v161
    v_cvt_pk_bf16_f32 v162, v162, v162
    v_cvt_pk_bf16_f32 v163, v163, v163
    v_cvt_pk_bf16_f32 v164, v164, v164
    v_cvt_pk_bf16_f32 v165, v165, v165
    v_cvt_pk_bf16_f32 v166, v166, v166
    v_cvt_pk_bf16_f32 v167, v167, v167
    s_lshl_b32 s55, s4, 3
    s_add_u32 s55, s55, s5
    s_lshl_b32 s55, s55, 10
    s_add_u32 s55, s55, 65536
    v_add_u32 v189, s55, v191
    s_lshl_b32 s55, s5, 2
    s_add_u32 s55, s55, s50
    s_lshl_b32 s55, s55, 7
    s_mul_i32 s54, s49, 45056
    s_add_u32 s55, s55, s54
    s_add_u32 s55, s55, 1703936
    v_lshrrev_b32 v199, 1, v2
    v_lshlrev_b32 v199, 12, v199
    v_lshrrev_b32 v180, 1, v3
    v_lshl_add_u32 v199, v180, 6, v199
    v_and_b32 v180, 1, v2
    v_lshl_add_u32 v199, v180, 5, v199
    v_and_b32 v180, 1, v3
    v_lshl_add_u32 v199, v180, 4, v199
    v_add_u32 v199, s55, v199
    v_add_u32 v198, 0x8000, v199
    v_and_b32 v72, v152, v172
    v_and_b32 v73, v152, v173
    v_and_b32 v74, v152, v174
    v_and_b32 v75, v152, v175
    v_and_b32 v76, v153, v172
    v_and_b32 v77, v153, v173
    v_and_b32 v78, v153, v174
    v_and_b32 v79, v153, v175
    s_waitcnt vmcnt(23)
    v_mfma_f32_16x16x32_bf16 v[240:243], v[72:75], v[8:11], 0
    v_and_b32 v80, v154, v172
    v_and_b32 v81, v154, v173
    v_and_b32 v82, v154, v174
    v_and_b32 v83, v154, v175
    s_waitcnt vmcnt(22)
    v_mfma_f32_16x16x32_bf16 v[240:243], v[76:79], v[12:15], v[240:243]
    v_and_b32 v84, v155, v172
    v_and_b32 v85, v155, v173
    v_and_b32 v86, v155, v174
    v_and_b32 v87, v155, v175
    s_waitcnt vmcnt(21)
    v_mfma_f32_16x16x32_bf16 v[240:243], v[80:83], v[16:19], v[240:243]
    v_and_b32 v88, v156, v172
    v_and_b32 v89, v156, v173
    v_and_b32 v90, v156, v174
    v_and_b32 v91, v156, v175
    s_waitcnt vmcnt(20)
    v_mfma_f32_16x16x32_bf16 v[240:243], v[84:87], v[20:23], v[240:243]
    v_and_b32 v92, v157, v172
    v_and_b32 v93, v157, v173
    v_and_b32 v94, v157, v174
    v_and_b32 v95, v157, v175
    s_waitcnt vmcnt(19)
    v_mfma_f32_16x16x32_bf16 v[240:243], v[88:91], v[24:27], v[240:243]
    v_and_b32 v96, v158, v172
    v_and_b32 v97, v158, v173
    v_and_b32 v98, v158, v174
    v_and_b32 v99, v158, v175
    s_waitcnt vmcnt(18)
    v_mfma_f32_16x16x32_bf16 v[240:243], v[92:95], v[28:31], v[240:243]
    v_and_b32 v100, v159, v172
    v_and_b32 v101, v159, v173
    v_and_b32 v102, v159, v174
    v_and_b32 v103, v159, v175
    s_waitcnt vmcnt(17)
    v_mfma_f32_16x16x32_bf16 v[240:243], v[96:99], v[32:35], v[240:243]
    v_and_b32 v104, v160, v172
    v_and_b32 v105, v160, v173
    v_and_b32 v106, v160, v174
    v_and_b32 v107, v160, v175
    s_waitcnt vmcnt(16)
    v_mfma_f32_16x16x32_bf16 v[240:243], v[100:103], v[36:39], v[240:243]
    v_and_b32 v108, v161, v172
    v_and_b32 v109, v161, v173
    v_and_b32 v110, v161, v174
    v_and_b32 v111, v161, v175
    s_waitcnt vmcnt(15)
    v_mfma_f32_16x16x32_bf16 v[240:243], v[104:107], v[40:43], v[240:243]
    v_and_b32 v112, v162, v172
    v_and_b32 v113, v162, v173
    v_and_b32 v114, v162, v174
    v_and_b32 v115, v162, v175
    s_waitcnt vmcnt(14)
    v_mfma_f32_16x16x32_bf16 v[240:243], v[108:111], v[44:47], v[240:243]
    v_and_b32 v116, v163, v172
    v_and_b32 v117, v163, v173
    v_and_b32 v118, v163, v174
    v_and_b32 v119, v163, v175
    s_waitcnt vmcnt(13)
    v_mfma_f32_16x16x32_bf16 v[240:243], v[112:115], v[48:51], v[240:243]
    v_and_b32 v120, v164, v172
    v_and_b32 v121, v164, v173
    v_and_b32 v122, v164, v174
    v_and_b32 v123, v164, v175
    s_waitcnt vmcnt(12)
    v_mfma_f32_16x16x32_bf16 v[240:243], v[116:119], v[52:55], v[240:243]
    v_and_b32 v124, v165, v172
    v_and_b32 v125, v165, v173
    v_and_b32 v126, v165, v174
    v_and_b32 v127, v165, v175
    s_waitcnt vmcnt(11)
    v_mfma_f32_16x16x32_bf16 v[240:243], v[120:123], v[56:59], v[240:243]
    v_and_b32 v128, v166, v172
    v_and_b32 v129, v166, v173
    v_and_b32 v130, v166, v174
    v_and_b32 v131, v166, v175
    s_waitcnt vmcnt(10)
    v_mfma_f32_16x16x32_bf16 v[240:243], v[124:127], v[60:63], v[240:243]
    v_and_b32 v132, v167, v172
    v_and_b32 v133, v167, v173
    v_and_b32 v134, v167, v174
    v_and_b32 v135, v167, v175
    s_waitcnt vmcnt(9)
    v_mfma_f32_16x16x32_bf16 v[240:243], v[128:131], v[64:67], v[240:243]
    s_waitcnt vmcnt(8)
    v_mfma_f32_16x16x32_bf16 v[240:243], v[132:135], v[68:71], v[240:243]
    s_getreg_b32 s96, hwreg(HW_REG_XCC_ID, 0, 4)
    s_waitcnt lgkmcnt(0)
    s_mul_i32 s97, s11, 0x9E3779B1
    s_add_u32 s97, s97, 0x7F4A7C15
    s_lshl_b32 s97, s97, 6
    s_or_b32 s97, s97, 32
    s_or_b32 s96, s96, s97
    s_or_b32 s97, s97, 16
    s_and_b32 s92, s96, 0xff
    s_bfe_u32 s93, s96, 0x80008
    s_bfe_u32 s94, s96, 0x80010
    s_lshr_b32 s95, s96, 24
    s_and_b32 s84, s97, 0xff
    s_bfe_u32 s85, s97, 0x80008
    s_bfe_u32 s86, s97, 0x80010
    s_lshr_b32 s87, s97, 24
    v_bfi_b32 v240, v185, s92, v240
    v_bfi_b32 v241, v185, s93, v241
    v_bfi_b32 v242, v185, s94, v242
    v_bfi_b32 v243, v185, s95, v243
    global_store_dwordx4 v189, v[240:243], s[62:63]
    s_waitcnt vmcnt(1)
    v_mfma_f32_16x16x32_bf16 v[244:247], v[72:75], v[208:211], 0
    v_mfma_f32_16x16x32_bf16 v[248:251], v[72:75], v[224:227], 0
    v_mfma_f32_16x16x32_bf16 v[244:247], v[76:79], v[212:215], v[244:247]
    v_mfma_f32_16x16x32_bf16 v[248:251], v[76:79], v[228:231], v[248:251]
    v_mfma_f32_16x16x32_bf16 v[244:247], v[80:83], v[216:219], v[244:247]
    v_mfma_f32_16x16x32_bf16 v[248:251], v[80:83], v[232:235], v[248:251]
    v_mfma_f32_16x16x32_bf16 v[244:247], v[84:87], v[220:223], v[244:247]
    v_mfma_f32_16x16x32_bf16 v[248:251], v[84:87], v[236:239], v[248:251]
    s_nop 6
    v_bfi_b32 v244, v185, s92, v244
    v_bfi_b32 v245, v185, s93, v245
    v_bfi_b32 v246, v185, s94, v246
    v_bfi_b32 v247, v185, s95, v247
    v_bfi_b32 v248, v185, s92, v248
    v_bfi_b32 v249, v185, s93, v249
    v_bfi_b32 v250, v185, s94, v250
    v_bfi_b32 v251, v185, s95, v251
    global_store_dwordx4 v199, v[244:247], s[62:63]
    s_mov_b32 exec_lo, 0x003f003f
    s_mov_b32 exec_hi, 0x003f003f
    global_store_dwordx4 v198, v[248:251], s[62:63]
    s_mov_b64 exec, 1
    ds_add_u32 v4, v5 offset:0
    s_mov_b64 exec, -1
    s_mov_b64 exec, 1
    ds_add_u32 v4, v5 offset:16
    s_mov_b64 exec, -1
    s_mov_b32 s43, 0x40000
L_v0:
    s_sleep 2
    ds_read_b32 v180, v4 offset:20
    s_sub_u32 s43, s43, 1
    s_cbranch_scc1 L_end
    s_waitcnt lgkmcnt(0)
    v_readfirstlane_b32 s48, v180
    s_nop 0
    s_cmp_eq_u32 s48, 0
    s_cbranch_scc1 L_v0
    s_cmp_eq_u32 s48, 1
    s_cbranch_scc1 L_wo
    v_bfi_b32 v240, v185, s84, v240
    v_bfi_b32 v241, v185, s85, v241
    v_bfi_b32 v242, v185, s86, v242
    v_bfi_b32 v243, v185, s87, v243
    v_bfi_b32 v244, v185, s84, v244
    v_bfi_b32 v245, v185, s85, v245
    v_bfi_b32 v246, v185, s86, v246
    v_bfi_b32 v247, v185, s87, v247
    v_bfi_b32 v248, v185, s84, v248
    v_bfi_b32 v249, v185, s85, v249
    v_bfi_b32 v250, v185, s86, v250
    v_bfi_b32 v251, v185, s87, v251
    global_store_dwordx4 v189, v[240:243], s[40:41] sc1
    global_store_dwordx4 v199, v[244:247], s[40:41] sc1
    s_mov_b32 exec_lo, 0x003f003f
    s_mov_b32 exec_hi, 0x003f003f
    global_store_dwordx4 v198, v[248:251], s[40:41] sc1
    s_mov_b64 exec, -1
    s_branch L_wo
L_P123:
    s_and_b32 s8, s5, 1
    s_lshr_b32 s9, s5, 1
    s_lshl1_add_u32 s10, s4, s8
    v_and_b32 v180, 1, v0
    v_lshlrev_b32 v180, 4, v180
    v_mov_b32 v181, 0xffff
    v_lshlrev_b32 v180, v180, v181
    v_bfe_u32 v181, v0, 1, 2
    v_cmp_eq_u32 s[80:81], 0, v181
    v_cmp_eq_u32 s[82:83], 1, v181
    v_cmp_eq_u32 s[84:85], 2, v181
    v_cmp_eq_u32 s[86:87], 3, v181
    v_mov_b32 v185, 0xff
    s_add_u32 s62, s40, 2097152
    s_addc_u32 s63, s41, 0
    v_cndmask_b32 v172, 0, v180, s[80:81]
    v_cndmask_b32 v173, 0, v180, s[82:83]
    v_cndmask_b32 v174, 0, v180, s[84:85]
    v_cndmask_b32 v175, 0, v180, s[86:87]
    s_getreg_b32 s96, hwreg(HW_REG_XCC_ID, 0, 4)
    s_waitcnt lgkmcnt(0)
    s_mul_i32 s97, s11, 0x9E3779B1
    s_add_u32 s97, s97, 0x7F4A7C15
    s_lshl_b32 s97, s97, 6
    s_or_b32 s97, s97, 32
    s_or_b32 s96, s96, s97
    s_or_b32 s97, s97, 16
    s_and_b32 s92, s96, 0xff
    s_bfe_u32 s93, s96, 0x80008
    s_bfe_u32 s94, s96, 0x80010
    s_lshr_b32 s95, s96, 24
    s_and_b32 s84, s97, 0xff
    s_bfe_u32 s85, s97, 0x80008
    s_bfe_u32 s86, s97, 0x80010
    s_lshr_b32 s87, s97, 24
    s_cmp_lg_u32 s3, 5
    s_cbranch_scc1 L_P23
    s_lshl_b32 s52, s4, 13
    s_lshl_b32 s53, s6, 9
    s_add_u32 s52, s52, s53
    s_add_u32 s52, s52, 65536
    v_lshrrev_b32 v188, 2, v2
    v_lshlrev_b32 v188, 11, v188
    v_and_b32 v180, 3, v0
    v_lshl_add_u32 v183, v3, 2, v180
    v_lshlrev_b32 v183, 4, v183
    v_add3_u32 v188, v188, v183, s52
    s_mov_b32 s43, 0x40000
    s_branch L_qp_in
L_qp:
    s_sleep 2
L_qp_in:
    ds_read_b32 v180, v4 offset:16
    s_sub_u32 s43, s43, 1
    s_cbranch_scc1 L_end
    s_waitcnt lgkmcnt(0)
    v_cmp_gt_u32 vcc, 5, v180
    s_cbranch_vccnz L_qp
    s_movk_i32 s43, 0x3fff
L_pq:
    s_and_b32 s48, s43, 63
    s_cselect_b64 s[60:61], s[62:63], s[40:41]
    global_load_dwordx4 v[8:11], v188, s[60:61] offset:0 sc1 nt
    global_load_dwordx4 v[12:15], v188, s[60:61] offset:256 sc1 nt
    global_load_dwordx4 v[16:19], v188, s[60:61] offset:1024 sc1 nt
    global_load_dwordx4 v[20:23], v188, s[60:61] offset:1280 sc1 nt
    s_cselect_b64 s[12:13], s[92:93], s[84:85]
    s_cselect_b64 s[14:15], s[94:95], s[86:87]
    s_cbranch_scc1 L_pqA
    v_mov_b32 v180, 2
    ds_write_b32 v4, v180 offset:20
L_pqA:
    s_sub_u32 s43, s43, 1
    s_cbranch_scc1 L_end
    s_waitcnt vmcnt(0)
    v_xor_b32 v8, s12, v8
    v_xor_b32 v9, s13, v9
    v_xor_b32 v10, s14, v10
    v_xor_b32 v11, s15, v11
    v_xor_b32 v12, s12, v12
    v_xor_b32 v13, s13, v13
    v_xor_b32 v14, s14, v14
    v_xor_b32 v15, s15, v15
    v_xor_b32 v16, s12, v16
    v_xor_b32 v17, s13, v17
    v_xor_b32 v18, s14, v18
    v_xor_b32 v19, s15, v19
    v_xor_b32 v20, s12, v20
    v_xor_b32 v21, s13, v21
    v_xor_b32 v22, s14, v22
    v_xor_b32 v23, s15, v23
    v_or3_b32 v180, v8, v9, v10
    v_or3_b32 v180, v180, v11, v12
    v_or3_b32 v180, v180, v13, v14
    v_or3_b32 v180, v180, v15, v16
    v_or3_b32 v180, v180, v17, v18
    v_or3_b32 v180, v180, v19, v20
    v_or3_b32 v180, v180, v21, v22
    v_or_b32 v180, v180, v23
    v_cmp_ne_u32_sdwa vcc, v180, v4 src0_sel:BYTE_0 src1_sel:DWORD
    s_cbranch_vccnz L_pq
    v_add_f32 v8, v8, v16
    v_add_f32 v9, v9, v17
    v_add_f32 v10, v10, v18
    v_add_f32 v11, v11, v19
    v_add_f32 v12, v12, v20
    v_add_f32 v13, v13, v21
    v_add_f32 v14, v14, v22
    v_add_f32 v15, v15, v23
L_qok:
    v_add_f32_dpp v8, v8, v8 row_ror:4 row_mask:0xf bank_mask:0xf
    v_add_f32_dpp v9, v9, v9 row_ror:4 row_mask:0xf bank_mask:0xf
    v_add_f32_dpp v10, v10, v10 row_ror:4 row_mask:0xf bank_mask:0xf
    v_add_f32_dpp v11, v11, v11 row_ror:4 row_mask:0xf bank_mask:0xf
    v_add_f32_dpp v12, v12, v12 row_ror:4 row_mask:0xf bank_mask:0xf
    v_add_f32_dpp v13, v13, v13 row_ror:4 row_mask:0xf bank_mask:0xf
    v_add_f32_dpp v14, v14, v14 row_ror:4 row_mask:0xf bank_mask:0xf
    v_add_f32_dpp v15, v15, v15 row_ror:4 row_mask:0xf bank_mask:0xf
    v_add_f32_dpp v8, v8, v8 row_ror:8 row_mask:0xf bank_mask:0xf
    v_add_f32_dpp v9, v9, v9 row_ror:8 row_mask:0xf bank_mask:0xf
    v_add_f32_dpp v10, v10, v10 row_ror:8 row_mask:0xf bank_mask:0xf
    v_add_f32_dpp v11, v11, v11 row_ror:8 row_mask:0xf bank_mask:0xf
    v_add_f32_dpp v12, v12, v12 row_ror:8 row_mask:0xf bank_mask:0xf
    v_add_f32_dpp v13, v13, v13 row_ror:8 row_mask:0xf bank_mask:0xf
    v_add_f32_dpp v14, v14, v14 row_ror:8 row_mask:0xf bank_mask:0xf
    v_add_f32_dpp v15, v15, v15 row_ror:8 row_mask:0xf bank_mask:0xf
    v_cvt_pk_bf16_f32 v16, v8, v9
    v_cvt_pk_bf16_f32 v17, v10, v11
    v_cvt_pk_bf16_f32 v18, v12, v13
    v_cvt_pk_bf16_f32 v19, v14, v15
    ds_write_b128 v183, v[16:19] offset:64
    s_mov_b64 exec, 1
    ds_add_u32 v4, v5 offset:0
    s_mov_b64 exec, -1
    s_branch L_wo
L_P23:
    s_mov_b64 exec, 1
    ds_add_u32 v4, v5 offset:0
    s_mov_b64 exec, -1
    s_and_b32 s52, s10, 7
    s_mul_i32 s51, s49, 11
    s_lshr_b32 s58, s52, 1
    s_add_u32 s58, s58, s51
    s_add_u32 s58, s58, 8
    s_add_u32 s51, s51, s52
    s_cmp_lt_u32 s52, 6
    s_cselect_b32 s58, s58, 86
    s_bitcmp1_b32 s52, 0
    s_cselect_b32 s56, 0, -1
    s_cselect_b32 s57, -1, 0
    s_cmp_eq_u32 s3, 7
    s_cselect_b32 s51, s51, s58
    s_cselect_b64 s[56:57], -1, s[56:57]
    s_cmp_ge_u32 s51, 86
    s_cbranch_scc1 L_wo
    v_mov_b32 v56, 0
    v_mov_b32 v88, 0
    v_mov_b32 v57, 0
    v_mov_b32 v89, 0
    v_mov_b32 v58, 0
    v_mov_b32 v90, 0
    v_mov_b32 v59, 0
    v_mov_b32 v91, 0
    v_mov_b32 v60, 0
    v_mov_b32 v92, 0
    v_mov_b32 v61, 0
    v_mov_b32 v93, 0
    v_mov_b32 v62, 0
    v_mov_b32 v94, 0
    v_mov_b32 v63, 0
    v_mov_b32 v95, 0
    v_mov_b32 v64, 0
    v_mov_b32 v96, 0
    v_mov_b32 v65, 0
    v_mov_b32 v97, 0
    v_mov_b32 v66, 0
    v_mov_b32 v98, 0
    v_mov_b32 v67, 0
    v_mov_b32 v99, 0
    v_mov_b32 v68, 0
    v_mov_b32 v100, 0
    v_mov_b32 v69, 0
    v_mov_b32 v101, 0
    v_mov_b32 v70, 0
    v_mov_b32 v102, 0
    v_mov_b32 v71, 0
    v_mov_b32 v103, 0
    v_lshlrev_b32 v193, 12, v3
    v_lshl_add_u32 v193, v2, 4, v193
    s_lshl_b32 s53, s9, 8
    s_lshl_b32 s55, s51, 14
    s_add_u32 s53, s53, s55
    v_add_u32 v193, s53, v193
    s_lshl_b32 s52, s51, 5
    v_lshlrev_b32 v183, 3, v3
    v_add_u32 v183, s52, v183
    global_load_dwordx2 v[136:137], v183, s[30:31]
    s_lshl_b32 s52, s51, 12
    s_add_u32 s52, s52, 1703936
    v_lshlrev_b32 v188, 7, v187
    v_lshl_add_u32 v188, v186, 6, v188
    v_lshl_add_u32 v188, v3, 4, v188
    v_add_u32 v188, s52, v188
    s_mov_b32 s43, 0x40000
    s_branch L_fq0_in
L_fq0:
    s_sleep 2
L_fq0_in:
    ds_read_b32 v180, v4 offset:0
    s_sub_u32 s43, s43, 1
    s_cbranch_scc1 L_end
    s_waitcnt lgkmcnt(0)
    v_cmp_gt_u32 vcc, 3, v180
    s_cbranch_vccnz L_fq0
    s_mov_b64 exec, s[56:57]
    global_load_dwordx4 v[56:59], v193, s[32:33] offset:0 nt
    global_load_dwordx4 v[60:63], v193, s[32:33] offset:1024 nt
    global_load_dwordx4 v[64:67], v193, s[32:33] offset:2048 nt
    global_load_dwordx4 v[68:71], v193, s[32:33] offset:3072 nt
    s_mov_b64 exec, -1
    s_mov_b32 s43, 0x40000
    s_branch L_fq_in
L_fq:
    s_sleep 2
L_fq_in:
    ds_read_b32 v180, v4 offset:16
    s_sub_u32 s43, s43, 1
    s_cbranch_scc1 L_end
    s_waitcnt lgkmcnt(0)
    v_cmp_gt_u32 vcc, 5, v180
    s_cbranch_vccnz L_fq
    s_mov_b64 exec, s[56:57]
    s_movk_i32 s43, 0x3fff
L_ph:
    s_and_b32 s48, s43, 63
    s_cselect_b64 s[60:61], s[62:63], s[40:41]
    global_load_dwordx4 v[8:11], v188, s[60:61] offset:0 sc1 nt
    global_load_dwordx4 v[12:15], v188, s[60:61] offset:1024 sc1 nt
    global_load_dwordx4 v[16:19], v188, s[60:61] offset:2048 sc1 nt
    global_load_dwordx4 v[20:23], v188, s[60:61] offset:3072 sc1 nt
    s_cselect_b64 s[12:13], s[92:93], s[84:85]
    s_cselect_b64 s[14:15], s[94:95], s[86:87]
    s_cbranch_scc1 L_phA
    v_mov_b32 v180, 2
    ds_write_b32 v4, v180 offset:20
L_phA:
    s_sub_u32 s43, s43, 1
    s_cbranch_scc1 L_end
    s_waitcnt vmcnt(0)
    v_xor_b32 v8, s12, v8
    v_xor_b32 v9, s13, v9
    v_xor_b32 v10, s14, v10
    v_xor_b32 v11, s15, v11
    v_xor_b32 v12, s12, v12
    v_xor_b32 v13, s13, v13
    v_xor_b32 v14, s14, v14
    v_xor_b32 v15, s15, v15
    v_xor_b32 v16, s12, v16
    v_xor_b32 v17, s13, v17
    v_xor_b32 v18, s14, v18
    v_xor_b32 v19, s15, v19
    v_xor_b32 v20, s12, v20
    v_xor_b32 v21, s13, v21
    v_xor_b32 v22, s14, v22
    v_xor_b32 v23, s15, v23
    v_or3_b32 v180, v8, v9, v10
    v_or3_b32 v180, v180, v11, v12
    v_or3_b32 v180, v180, v13, v14
    v_or3_b32 v180, v180, v15, v16
    v_or3_b32 v180, v180, v17, v18
    v_or3_b32 v180, v180, v19, v20
    v_or3_b32 v180, v180, v21, v22
    v_or_b32 v180, v180, v23
    v_cmp_ne_u32_sdwa vcc, v180, v4 src0_sel:BYTE_0 src1_sel:DWORD
    s_cbranch_vccnz L_ph
L_hok:
    s_mov_b64 exec, 1
    ds_max_u32 v4, v5 offset:20
    s_mov_b64 exec, s[56:57]
    v_add_f32 v8, v8, v16
    v_add_f32 v9, v9, v17
    v_add_f32 v10, v10, v18
    v_add_f32 v11, v11, v19
    v_add_f32 v12, v12, v20
    v_add_f32 v13, v13, v21
    v_add_f32 v14, v14, v22
    v_add_f32 v15, v15, v23
    v_add_f32 v8, v8, v12
    v_add_f32 v9, v9, v13
    v_add_f32 v10, v10, v14
    v_add_f32 v11, v11, v15
    v_lshlrev_b32 v12, 16, v136
    v_and_b32 v13, 0xffff0000, v136
    v_add_f32_dpp v8, v8, v8 quad_perm:[1,0,3,2] row_mask:0xf bank_mask:0xf
    v_add_f32_dpp v9, v9, v9 quad_perm:[1,0,3,2] row_mask:0xf bank_mask:0xf
    v_add_f32_dpp v10, v10, v10 quad_perm:[1,0,3,2] row_mask:0xf bank_mask:0xf
    v_add_f32_dpp v11, v11, v11 quad_perm:[1,0,3,2] row_mask:0xf bank_mask:0xf
    v_add_f32_dpp v8, v8, v8 quad_perm:[2,3,0,1] row_mask:0xf bank_mask:0xf
    v_add_f32_dpp v9, v9, v9 quad_perm:[2,3,0,1] row_mask:0xf bank_mask:0xf
    v_add_f32_dpp v10, v10, v10 quad_perm:[2,3,0,1] row_mask:0xf bank_mask:0xf
    v_add_f32_dpp v11, v11, v11 quad_perm:[2,3,0,1] row_mask:0xf bank_mask:0xf
    v_add_f32_dpp v8, v8, v8 row_half_mirror row_mask:0xf bank_mask:0xf
    v_add_f32_dpp v9, v9, v9 row_half_mirror row_mask:0xf bank_mask:0xf
    v_add_f32_dpp v10, v10, v10 row_half_mirror row_mask:0xf bank_mask:0xf
    v_add_f32_dpp v11, v11, v11 row_half_mirror row_mask:0xf bank_mask:0xf
    v_lshlrev_b32 v14, 16, v137
    v_and_b32 v15, 0xffff0000, v137
    v_add_f32 v8, v8, v12
    v_add_f32 v9, v9, v13
    v_add_f32 v10, v10, v14
    v_add_f32 v11, v11, v15
    v_max_f32 v8, 0, v8
    v_max_f32 v9, 0, v9
    v_max_f32 v10, 0, v10
    v_max_f32 v11, 0, v11
    v_mul_f32 v8, v8, v8
    v_mul_f32 v9, v9, v9
    v_mul_f32 v10, v10, v10
    v_mul_f32 v11, v11, v11
    v_cvt_pk_bf16_f32 v8, v8, v8
    v_cvt_pk_bf16_f32 v9, v9, v9
    v_cvt_pk_bf16_f32 v10, v10, v10
    v_cvt_pk_bf16_f32 v11, v11, v11
    v_and_b32 v88, v8, v172
    v_and_b32 v89, v8, v173
    v_and_b32 v90, v8, v174
    v_and_b32 v91, v8, v175
    v_and_b32 v92, v9, v172
    v_and_b32 v93, v9, v173
    v_and_b32 v94, v9, v174
    v_and_b32 v95, v9, v175
    v_and_b32 v96, v10, v172
    v_and_b32 v97, v10, v173
    v_and_b32 v98, v10, v174
    v_and_b32 v99, v10, v175
    v_and_b32 v100, v11, v172
    v_and_b32 v101, v11, v173
    v_and_b32 v102, v11, v174
    v_and_b32 v103, v11, v175
    s_mov_b64 exec, -1
    v_mfma_f32_16x16x32_bf16 v[176:179], v[88:91], v[56:59], 0
    v_mfma_f32_16x16x32_bf16 v[176:179], v[92:95], v[60:63], v[176:179]
    v_mfma_f32_16x16x32_bf16 v[176:179], v[96:99], v[64:67], v[176:179]
    v_mfma_f32_16x16x32_bf16 v[176:179], v[100:103], v[68:71], v[176:179]
    v_bfe_u32 v199, v0, 1, 4
    v_and_b32 v181, 1, v0
    v_lshl_add_u32 v199, v181, 4, v199
    v_and_or_b32 v199, v0, 32, v199
    v_lshlrev_b32 v199, 4, v199
    s_lshl_b32 s52, s3, 10
    s_and_b32 s52, s52, 1024
    v_add_u32 v182, s52, v191
    ds_write_b128 v182, v[176:179] offset:4608
    s_cmp_lt_u32 s58, 86
    s_cbranch_scc1 L_f2u
    ds_read_b128 v[176:179], v199 offset:5632
    s_waitcnt lgkmcnt(0)
    s_branch L_f1
L_f2u:
    s_mov_b64 exec, 1
    ds_add_rtn_u32 v180, v4, v5 offset:24
    s_waitcnt lgkmcnt(0)
    v_cmp_ne_u32 vcc, 1, v180
    s_mov_b64 exec, -1
    s_cbranch_vccnz L_wo
    ds_read_b128 v[8:11], v199 offset:4608
    ds_read_b128 v[176:179], v199 offset:5632
    s_waitcnt lgkmcnt(0)
    v_add_f32 v176, v176, v8
    v_add_f32 v177, v177, v9
    v_add_f32 v178, v178, v10
    v_add_f32 v179, v179, v11
L_f1:
    v_bfi_b32 v240, v185, s84, v176
    v_bfi_b32 v241, v185, s85, v177
    v_bfi_b32 v242, v185, s86, v178
    v_bfi_b32 v243, v185, s87, v179
    s_mov_b32 s57, 1
    s_branch L_wo2
L_wo:
    s_mov_b32 s57, 0
L_wo2:
    v_lshlrev_b32 v193, 12, v3
    v_lshl_add_u32 v193, v2, 4, v193
    s_lshl_b32 s53, s9, 8
    v_add_u32 v193, s53, v193
    s_sub_u32 s51, s3, 4
    s_lshl_b32 s52, s10, 16
    s_lshl_b32 s53, s51, 14
    s_add_u32 s52, s52, s53
    s_add_u32 s24, s24, s52
    s_addc_u32 s25, s25, 0
    s_lshl_b32 s52, s8, 2
    s_add_u32 s52, s52, s51
    s_lshl_b32 s52, s52, 11
    s_lshl_b32 s53, s4, 14
    s_add_u32 s52, s52, s53
    s_add_u32 s52, s52, 524288
    v_lshl_add_u32 v188, v186, 4, v187
    v_lshlrev_b32 v188, 6, v188
    v_lshl_add_u32 v188, v3, 4, v188
    v_add_u32 v188, s52, v188
    s_lshl_b32 s52, s51, 10
    v_add_u32 v182, s52, v191
    s_lshl_b32 s52, s9, 6
    s_add_u32 s52, s52, s10
    s_mul_i32 s52, s52, 1152
    s_add_u32 s52, s52, 1048576
    v_add_u32 v184, s52, v191
    v_add_u32 v189, 327680, v184
    v_and_b32 v197, 1, v3
    v_lshrrev_b32 v180, 1, v3
    v_lshl_or_b32 v197, v197, 1, v180
    v_bfe_u32 v199, v0, 1, 4
    v_and_b32 v181, 1, v0
    v_lshl_add_u32 v199, v181, 4, v199
    v_and_or_b32 v199, v0, 32, v199
    v_lshlrev_b32 v199, 4, v199
    s_lshr_b32 s54, s49, 1
    s_and_b32 s55, s49, 1
    s_lshl2_add_u32 s56, s5, s50
    s_lshl_b32 s52, s56, 2
    s_lshl_b32 s53, s54, 7
    s_add_u32 s52, s52, s53
    v_add_lshl_u32 v197, v197, s52, 1
    s_lshl_b32 s52, s55, 10
    v_add_u32 v192, s52, v197
    s_mul_i32 s52, s54, 73728
    s_lshl_b32 s53, s55, 9
    s_add_u32 s52, s52, s53
    s_lshl4_add_u32 s52, s56, s52
    s_add_u32 s52, s52, 1048576
    v_mul_u32_u24 v190, 1152, v0
    v_add_u32 v190, s52, v190
    v_add_u32 v183, 327680, v190
    global_load_ushort v195, v197, s[34:35]
    global_load_ushort v196, v192, s[16:17]
    s_mov_b32 s43, 0x40000
    s_branch L_pv_in
L_pv:
    s_sleep 1
L_pv_in:
    ds_read_b32 v180, v4 offset:4
    s_sub_u32 s43, s43, 1
    s_cbranch_scc1 L_end
    s_waitcnt lgkmcnt(0)
    v_cmp_gt_u32 vcc, 4, v180
    s_cbranch_vccnz L_pv
    global_load_dwordx4 v[40:43], v193, s[24:25] offset:0 nt
    global_load_dwordx4 v[44:47], v193, s[24:25] offset:1024 nt
    global_load_dwordx4 v[48:51], v193, s[24:25] offset:2048 nt
    global_load_dwordx4 v[52:55], v193, s[24:25] offset:3072 nt
L_wod:
    s_cmp_eq_u32 s57, 0
    s_cbranch_scc1 L_nfs
    global_store_dwordx4 v189, v[240:243], s[40:41] sc1
L_nfs:
    s_cmp_lg_u32 s3, 5
    s_cbranch_scc1 L_nyf
    s_and_b32 s52, s56, 7
    s_lshl_b32 s52, s52, 3
    s_lshl_b64 exec, 0xff, s52
    global_load_dword v204, v190, s[40:41] sc1
    s_mov_b64 exec, -1
L_nyf:
    s_mov_b32 s43, 0x40000
L_pw:
    ds_read_b32 v180, v4 offset:12
    s_sub_u32 s43, s43, 1
    s_cbranch_scc1 L_end
    s_waitcnt lgkmcnt(0)
    v_cmp_gt_u32 vcc, 4, v180
    s_cbranch_vccnz L_pw
    s_movk_i32 s43, 0x3fff
L_po:
    s_and_b32 s48, s43, 63
    s_cselect_b64 s[60:61], s[62:63], s[40:41]
    global_load_dwordx4 v[152:155], v188, s[60:61] sc1 nt
    global_load_dwordx4 v[156:159], v188, s[60:61] offset:512 sc1 nt
    s_cselect_b32 s42, s96, s97
    s_sub_u32 s43, s43, 1
    s_cbranch_scc1 L_end
    s_waitcnt vmcnt(0)
    v_cmp_ne_u32 vcc, s42, v155
    v_cmp_ne_u32 s[58:59], s42, v159
    v_max_f32 v180, v154, v158
    s_or_b64 exec, vcc, s[58:59]
    s_cbranch_scc1 L_po
    s_mov_b64 exec, -1
    v_max_f32_dpp v180, v180, v180 quad_perm:[1,0,3,2] row_mask:0xf bank_mask:0xf
    v_lshlrev_b32 v138, 16, v153
    v_and_b32 v139, 0xffff0000, v153
    v_max_f32_dpp v180, v180, v180 quad_perm:[2,3,0,1] row_mask:0xf bank_mask:0xf
    v_lshlrev_b32 v136, 16, v152
    v_and_b32 v137, 0xffff0000, v152
    v_max_f32_dpp v180, v180, v180 row_half_mirror row_mask:0xf bank_mask:0xf
    v_sub_f32 v155, v154, v180
    v_sub_f32 v159, v158, v180
    v_exp_f32 v155, v155
    v_exp_f32 v159, v159
    s_nop 0
    v_add_f32 v180, v155, v159
    v_lshlrev_b32 v140, 16, v156
    v_and_b32 v141, 0xffff0000, v156
    v_add_f32_dpp v180, v180, v180 quad_perm:[1,0,3,2] row_mask:0xf bank_mask:0xf
    v_lshlrev_b32 v142, 16, v157
    v_and_b32 v143, 0xffff0000, v157
    v_add_f32_dpp v180, v180, v180 quad_perm:[2,3,0,1] row_mask:0xf bank_mask:0xf
    v_pk_mul_f32 v[136:137], v[136:137], v[154:155] op_sel:[0,1] op_sel_hi:[1,1]
    v_pk_mul_f32 v[138:139], v[138:139], v[154:155] op_sel:[0,1] op_sel_hi:[1,1]
    v_add_f32_dpp v180, v180, v180 row_half_mirror row_mask:0xf bank_mask:0xf
    v_pk_fma_f32 v[136:137], v[140:141], v[158:159], v[136:137] op_sel:[0,1,0] op_sel_hi:[1,1,1]
    v_rcp_f32 v180, v180
    v_pk_fma_f32 v[138:139], v[142:143], v[158:159], v[138:139] op_sel:[0,1,0] op_sel_hi:[1,1,1]
    v_pk_mul_f32 v[136:137], v[136:137], v[180:181] op_sel:[0,0] op_sel_hi:[1,0]
    v_pk_mul_f32 v[138:139], v[138:139], v[180:181] op_sel:[0,0] op_sel_hi:[1,0]
    s_nop 0
    v_add_f32_dpp v136, v136, v136 quad_perm:[1,0,3,2] row_mask:0xf bank_mask:0xf
    v_add_f32_dpp v137, v137, v137 quad_perm:[1,0,3,2] row_mask:0xf bank_mask:0xf
    v_add_f32_dpp v138, v138, v138 quad_perm:[1,0,3,2] row_mask:0xf bank_mask:0xf
    v_add_f32_dpp v139, v139, v139 quad_perm:[1,0,3,2] row_mask:0xf bank_mask:0xf
    v_add_f32_dpp v136, v136, v136 quad_perm:[2,3,0,1] row_mask:0xf bank_mask:0xf
    v_add_f32_dpp v137, v137, v137 quad_perm:[2,3,0,1] row_mask:0xf bank_mask:0xf
    v_add_f32_dpp v138, v138, v138 quad_perm:[2,3,0,1] row_mask:0xf bank_mask:0xf
    v_add_f32_dpp v139, v139, v139 quad_perm:[2,3,0,1] row_mask:0xf bank_mask:0xf
    v_add_f32_dpp v136, v136, v136 row_half_mirror row_mask:0xf bank_mask:0xf
    v_add_f32_dpp v137, v137, v137 row_half_mirror row_mask:0xf bank_mask:0xf
    v_add_f32_dpp v138, v138, v138 row_half_mirror row_mask:0xf bank_mask:0xf
    v_add_f32_dpp v139, v139, v139 row_half_mirror row_mask:0xf bank_mask:0xf
    v_cvt_pk_bf16_f32 v136, v136, v136
    v_cvt_pk_bf16_f32 v137, v137, v137
    v_cvt_pk_bf16_f32 v138, v138, v138
    v_cvt_pk_bf16_f32 v139, v139, v139
    v_and_b32 v72, v136, v172
    v_and_b32 v73, v136, v173
    v_and_b32 v74, v136, v174
    v_and_b32 v75, v136, v175
    v_and_b32 v76, v137, v172
    v_and_b32 v77, v137, v173
    v_and_b32 v78, v137, v174
    v_and_b32 v79, v137, v175
    v_mfma_f32_16x16x32_bf16 v[176:179], v[72:75], v[40:43], 0
    v_and_b32 v80, v138, v172
    v_and_b32 v81, v138, v173
    v_and_b32 v82, v138, v174
    v_and_b32 v83, v138, v175
    v_mfma_f32_16x16x32_bf16 v[176:179], v[76:79], v[44:47], v[176:179]
    v_and_b32 v84, v139, v172
    v_and_b32 v85, v139, v173
    v_and_b32 v86, v139, v174
    v_and_b32 v87, v139, v175
    v_mfma_f32_16x16x32_bf16 v[176:179], v[80:83], v[48:51], v[176:179]
    s_nop 0
    v_mfma_f32_16x16x32_bf16 v[176:179], v[84:87], v[52:55], v[176:179]
    s_nop 7
    ds_write_b128 v182, v[176:179] offset:512
    s_mov_b64 exec, 1
    ds_add_rtn_u32 v180, v4, v5 offset:8
    s_mov_b64 exec, -1
    ds_read_b128 v[8:11], v199 offset:512
    ds_read_b128 v[12:15], v199 offset:1536
    ds_read_b128 v[16:19], v199 offset:2560
    ds_read_b128 v[20:23], v199 offset:3584
    s_waitcnt lgkmcnt(4)
    v_readfirstlane_b32 s48, v180
    s_nop 0
    s_cmp_lg_u32 s48, 3
    s_cbranch_scc1 L_end
    s_waitcnt lgkmcnt(2)
    v_pk_add_f32 v[8:9], v[8:9], v[12:13]
    v_pk_add_f32 v[10:11], v[10:11], v[14:15]
    s_waitcnt lgkmcnt(0)
    v_pk_add_f32 v[16:17], v[16:17], v[20:21]
    v_pk_add_f32 v[18:19], v[18:19], v[22:23]
    v_pk_add_f32 v[8:9], v[8:9], v[16:17]
    v_pk_add_f32 v[10:11], v[10:11], v[18:19]
    v_bfi_b32 v8, v185, s84, v8
    v_bfi_b32 v9, v185, s85, v9
    v_bfi_b32 v10, v185, s86, v10
    v_bfi_b32 v11, v185, s87, v11
    global_store_dwordx4 v184, v[8:11], s[40:41] sc1
    s_movk_i32 s43, 0x3fff
L_pf:
    global_load_dwordx4 v[200:203], v183, s[40:41] sc1
    s_sub_u32 s43, s43, 1
    s_cbranch_scc1 L_end
    s_waitcnt vmcnt(0)
    v_xor_b32 v200, s84, v200
    v_xor_b32 v201, s85, v201
    v_xor_b32 v202, s86, v202
    v_xor_b32 v203, s87, v203
    v_or3_b32 v180, v200, v201, v202
    v_or_b32 v180, v180, v203
    v_cmp_ne_u32_sdwa vcc, v180, v4 src0_sel:BYTE_0 src1_sel:DWORD
    s_cbranch_vccnz L_pf
    global_load_dwordx4 v[204:207], v190, s[40:41] sc1
    v_permlane32_swap_b32 v200, v201
    v_permlane32_swap_b32 v202, v203
    v_add_f32 v200, v200, v201
    v_add_f32 v202, v202, v203
    s_nop 1
    v_permlane16_swap_b32 v200, v202
    v_add_f32 v200, v200, v202
    s_nop 1
    v_add_f32_dpp v200, v200, v200 row_ror:8 row_mask:0xf bank_mask:0xf
    s_nop 1
    v_add_f32_dpp v200, v200, v200 row_ror:4 row_mask:0xf bank_mask:0xf
    s_nop 1
    v_add_f32_dpp v200, v200, v200 row_ror:2 row_mask:0xf bank_mask:0xf
    s_nop 1
    v_add_f32_dpp v200, v200, v200 row_ror:1 row_mask:0xf bank_mask:0xf
    v_lshlrev_b32 v195, 16, v195
    v_lshlrev_b32 v196, 16, v196
    v_add_f32 v195, v200, v195
    v_mul_f32 v180, 0xbfb8aa3b, v195
    v_exp_f32 v180, v180
    s_nop 0
    v_add_f32 v180, 1.0, v180
    v_rcp_f32 v180, v180
    s_movk_i32 s43, 0x3fff
    v_mul_f32 v195, v195, v180
    s_branch L_py_in
L_py:
    global_load_dwordx4 v[204:207], v190, s[40:41] sc1
    s_sub_u32 s43, s43, 1
    s_cbranch_scc1 L_end
L_py_in:
    s_waitcnt vmcnt(0)
    v_xor_b32 v204, s84, v204
    v_xor_b32 v205, s85, v205
    v_xor_b32 v206, s86, v206
    v_xor_b32 v207, s87, v207
    v_or3_b32 v180, v204, v205, v206
    v_or_b32 v180, v180, v207
    v_cmp_ne_u32_sdwa vcc, v180, v4 src0_sel:BYTE_0 src1_sel:DWORD
    s_nop 0
    s_and_b64 exec, vcc, vcc
    s_cbranch_scc1 L_py
    s_mov_b64 exec, -1
    v_permlane32_swap_b32 v204, v205
    v_permlane32_swap_b32 v206, v207
    v_add_f32 v204, v204, v205
    v_add_f32 v206, v206, v207
    s_nop 1
    v_permlane16_swap_b32 v204, v206
    v_add_f32 v204, v204, v206
    s_nop 1
    v_add_f32_dpp v204, v204, v204 row_ror:8 row_mask:0xf bank_mask:0xf
    s_nop 1
    v_add_f32_dpp v204, v204, v204 row_ror:4 row_mask:0xf bank_mask:0xf
    s_nop 1
    v_add_f32_dpp v204, v204, v204 row_ror:2 row_mask:0xf bank_mask:0xf
    s_nop 1
    v_add_f32_dpp v204, v204, v204 row_ror:1 row_mask:0xf bank_mask:0xf
    s_mov_b32 exec_lo, 0x00010001
    s_mov_b32 exec_hi, 0x00010001
    v_fma_f32 v204, v204, v195, v196
    v_cvt_pk_bf16_f32 v204, v204, v204
    global_store_short v192, v204, s[36:37]
    s_cmp_lg_u32 s2, 0
    s_cbranch_scc1 L_end
    s_add_u32 s11, s11, 1
    v_mov_b32 v180, s11
    s_mov_b64 exec, 1
    global_store_dword v4, v180, s[40:41]
L_end:
L_exit:
L_last:
    s_endpgm
.section .rodata,"a"
.p2align 6
.amdhsa_kernel recurrent_scan__sliding_block_cached__dense_activation_squared_relu__decode_kernel
  .amdhsa_next_free_vgpr 256
  .amdhsa_next_free_sgpr 100
  .amdhsa_accum_offset 256
  .amdhsa_group_segment_fixed_size 0
  .amdhsa_kernarg_size 104
  .amdhsa_user_sgpr_count 2
  .amdhsa_user_sgpr_kernarg_segment_ptr 1
  .amdhsa_system_sgpr_workgroup_id_x 1
.end_amdhsa_kernel
```
